```python
import torch

def _softmax(x, axis=-1):
    return torch.softmax(x, dim=axis)
def _gelu(x):
    return torch.nn.functional.gelu(x, approximate="tanh")
def _silu(x):
    return torch.nn.functional.silu(x)
def _sigmoid(x):
    return torch.sigmoid(x)
def _layernorm(x, axis=-1, eps=1e-5):
    m = x.mean(dim=axis, keepdim=True)
    v = x.var(dim=axis, keepdim=True, unbiased=False)
    return (x - m) / torch.sqrt(v + eps)
def _scatter_add(tgt, idx, src, axis=0):
    return tgt.clone().index_add_(axis, idx, src)
def _segment_sum(src, seg, n):
    out = torch.zeros((n,) + src.shape[1:], dtype=src.dtype)
    return out.index_add_(0, seg, src)
def _pad(x, pw):
    flat = tuple(v for pair in reversed(pw) for v in pair)
    return torch.nn.functional.pad(x, flat)

kernel_name = 'standalone__self_sup_conv_stem_hubert__speech'

def setup_inputs():

    _w = (lambda a: (lambda t: t.to(torch.bfloat16) if t.is_floating_point() else t)(torch.as_tensor(a)))
    B, T, D, K = 2, 1000, 512, 15
    scale = (1.0 / (K * D)) ** 0.5
    return {
        "x": _w((lambda *s: torch.randn(*s, dtype=torch.bfloat16) * 0.05)(B, T, D)),
        "w": _w((lambda *s: torch.randn(*s, dtype=torch.bfloat16) * 0.05)(K, D, D) * scale),
        "b": _w((lambda *s: torch.randn(*s, dtype=torch.bfloat16) * 0.05)(D) * 0.1),
        "gamma": _w(torch.ones((D,), dtype=float)),
        "beta": _w(torch.zeros((D,), dtype=float)),
    }

def reference(x, w, b, gamma, beta):
    B, T, D = x.shape
    K = w.shape[0]
    s = 2
    L = (T - K) // s + 1
    y = torch.einsum('blc,cd->bld', x[:, 0 : s * L : s, :], w[0])
    for i in range(1, K):
        y = y + torch.einsum('blc,cd->bld', x[:, i : i + s * L : s, :], w[i])
    y = y + b[None, None, :]
    mu = y.mean(1, keepdims=True)
    var = ((y - mu) ** 2).mean(1, keepdims=True)
    yn = (y - mu) / torch.sqrt(var + 1e-5)
    yn = yn * gamma[None, None, :] + beta[None, None, :]
    return _gelu(yn)
```

```asm
; @launch grid=(256,1,1) block=(512,1,1) lds=154240
.amdgcn_target "amdgcn-amd-amdhsa--gfx950"
.text
.globl standalone__self_sup_conv_stem_hubert__speech_kernel
.p2align 8
.type standalone__self_sup_conv_stem_hubert__speech_kernel,@function
standalone__self_sup_conv_stem_hubert__speech_kernel:
    s_cmp_ge_u32 s2, 256
    s_cbranch_scc1 L_end
    s_load_dwordx16 s[64:79], s[0:1], 0
    s_getpc_b64 s[4:5]
L_pc:
    v_lshrrev_b32 v132, 6, v0
    v_and_b32 v133, 7, v0
    v_lshl_add_u32 v132, v132, 3, v133
    v_lshlrev_b32 v132, 7, v132
    s_sub_u32 s4, s4, L_pc-standalone__self_sup_conv_stem_hubert__speech_kernel
    s_subb_u32 s5, s5, 0
    v_min_u32 v132, L_end-standalone__self_sup_conv_stem_hubert__speech_kernel, v132
    global_load_dword v133, v132, s[4:5]
    v_mov_b32 v10, 153988
    v_mov_b32 v11, 0
    ds_write_b32 v10, v11
    s_and_b32 s24, s2, 7
    s_lshr_b32 s25, s2, 3
    s_and_b32 s26, s24, 1
    s_and_b32 s27, s24, 6
    s_lshr_b32 s40, s25, 4
    s_add_u32 s27, s27, s40
    s_lshr_b32 s28, s25, 2
    s_and_b32 s28, s28, 3
    s_and_b32 s29, s25, 3
    s_and_b32 s30, s25, 15
    s_lshl_b32 s31, s26, 3
    s_add_u32 s31, s31, s27
    v_lshrrev_b32 v10, 6, v0
    v_and_b32 v1, 63, v0
    v_readfirstlane_b32 s32, v10
    v_lshrrev_b32 v10, 3, v1
    v_and_b32 v11, 7, v1
    v_lshlrev_b32 v2, 11, v10
    v_lshl_add_u32 v2, v11, 4, v2
    s_and_b32 s33, s32, 3
    s_mul_i32 s34, s26, 1024000
    s_add_u32 s42, s34, 1024000
    s_lshl_b32 s40, s28, 18
    s_add_u32 s34, s34, s40
    s_lshl_b32 s40, s29, 8
    s_add_u32 s34, s34, s40
    s_lshl_b32 s40, s33, 14
    s_add_u32 s35, s34, s40
    s_mul_i32 s36, s33, 1056
    s_lshl_b32 s37, s29, 17
    s_lshl_b32 s40, s33, 13
    s_add_u32 s37, s37, s40
    s_lshl_b32 s40, s27, 7
    s_add_u32 s37, s37, s40
    s_lshl_b32 s38, s33, 10
    s_add_u32 s38, s38, 71808
    s_lshl_b32 s41, s30, 3
    s_add_u32 s39, s40, s41
    v_bfe_u32 v12, v1, 4, 1
    s_and_b32 s41, s33, 1
    s_lshl_b32 s41, s41, 1
    v_or_b32 v12, s41, v12
    v_lshrrev_b32 v13, 1, v11
    v_xor_b32 v12, v13, v12
    v_lshlrev_b32 v3, 10, v10
    v_lshl_add_u32 v3, v12, 5, v3
    v_and_b32 v13, 1, v1
    v_lshl_add_u32 v3, v13, 4, v3
    s_lshr_b32 s55, s32, 2
    s_mul_i32 s56, s55, 17952
    s_add_u32 s56, s56, s36
    s_lshl_b32 s57, s55, 10
    s_add_u32 s57, s57, s35
    s_mul_i32 s58, s55, 5242880
    s_add_u32 s58, s58, s37
    s_mul_i32 s59, s55, 2621440
    s_sub_u32 s59, s37, s59
    s_mul_i32 s60, s55, 20480
    s_add_u32 s60, s60, s38
    s_mov_b32 s14, s42
    s_mov_b32 s15, 0x20000
    s_mov_b32 s18, 7864320
    s_mov_b32 s19, 0x20000
    v_mov_b32 v20, 0
    s_cmp_eq_u32 s32, 7
    s_cbranch_scc0 L_nopremall
    v_lshrrev_b32 v20, 1, v1
    v_min_u32 v20, 9, v20
    s_mul_i32 s40, s2, 10
    v_add_u32 v20, s40, v20
    v_lshrrev_b32 v21, 7, v20
    v_and_b32 v20, 127, v20
    v_lshrrev_b32 v22, 5, v20
    v_and_b32 v20, 31, v20
    v_lshlrev_b32 v20, 10, v20
    v_lshl_or_b32 v20, v22, 17, v20
    v_cmp_le_u32 vcc, 15, v21
    v_subrev_u32 v22, 15, v21
    s_nop 0
    v_cndmask_b32 v22, v21, v22, vcc
    v_cndmask_b32 v23, 0, 1, vcc
    v_lshl_or_b32 v20, v23, 15, v20
    v_lshlrev_b32 v23, 1, v22
    v_cmp_gt_u32 vcc, 8, v22
    v_subrev_u32 v21, 15, v23
    s_nop 0
    v_cndmask_b32 v23, v21, v23, vcc
    v_lshl_or_b32 v20, v23, 19, v20
    v_and_b32 v21, 1, v1
    v_lshl_or_b32 v20, v21, 6, v20
L_nopremall:
    s_waitcnt lgkmcnt(0)
    s_barrier
    s_mov_b32 s12, s64
    s_and_b32 s13, s65, 0xffff
    s_mov_b32 s16, s66
    s_and_b32 s17, s67, 0xffff
    s_cmp_eq_u32 s32, 7
    s_cbranch_scc0 L_nopremall2
    s_movk_i32 s40, 384
    buffer_load_dword v134, v20, s[16:19], s40 offen
L_nopremall2:
    s_add_u32 m0, s60, 0
    s_add_u32 s40, s58, 0
    buffer_load_dwordx4 v3, s[16:19], s40 offen lds
    s_add_u32 m0, s60, 4096
    s_add_u32 s40, s58, 1048576
    buffer_load_dwordx4 v3, s[16:19], s40 offen lds
    s_add_u32 m0, s60, 8192
    s_add_u32 s40, s58, 2097152
    buffer_load_dwordx4 v3, s[16:19], s40 offen lds
    s_add_u32 m0, s60, 12288
    s_add_u32 s40, s59, 3145728
    buffer_load_dwordx4 v3, s[16:19], s40 offen lds
    s_add_u32 m0, s60, 16384
    s_add_u32 s40, s59, 4194304
    buffer_load_dwordx4 v3, s[16:19], s40 offen lds
    s_add_u32 m0, s56, 0
    s_add_u32 s40, s57, 0
    buffer_load_dwordx4 v2, s[12:15], s40 offen lds
    s_add_u32 m0, s56, 4224
    s_add_u32 s40, s57, 65536
    buffer_load_dwordx4 v2, s[12:15], s40 offen lds
    s_add_u32 m0, s56, 8448
    s_add_u32 s40, s57, 131072
    buffer_load_dwordx4 v2, s[12:15], s40 offen lds
    s_add_u32 m0, s56, 12672
    s_add_u32 s40, s57, 196608
    buffer_load_dwordx4 v2, s[12:15], s40 offen lds
    s_cmp_eq_u32 s33, s55
    s_cbranch_scc0 L_skipx01
    s_mul_i32 s41, s55, 17952
    s_add_u32 m0, s41, 16896
    s_lshl_b32 s41, s55, 10
    s_add_u32 s41, s41, s34
    s_add_u32 s40, s41, 262144
    buffer_load_dwordx4 v2, s[12:15], s40 offen lds
L_skipx01:
    s_cmp_ge_u32 s32, 4
    s_cbranch_scc1 L_loader
    s_mov_b32 s20, s78
    s_and_b32 s21, s79, 0xffff
    s_mov_b32 s22, 268435456
    s_mov_b32 s23, 0x20000
    s_mov_b32 s48, s74
    s_and_b32 s49, s75, 0xffff
    s_mov_b32 s50, 1009664
    s_mov_b32 s51, 0x20000
    s_load_dwordx2 s[4:5], s[68:69], s39
    s_load_dwordx2 s[6:7], s[70:71], s39
    s_load_dwordx2 s[8:9], s[72:73], s39
    s_lshl_b32 s41, s31, 7
    s_add_u32 s41, s41, 4227072
    s_load_dword s52, s[78:79], s41
    v_and_b32 v10, 15, v1
    v_lshrrev_b32 v11, 4, v1
    v_mul_u32_u24 v4, 1056, v10
    v_lshl_add_u32 v4, v11, 4, v4
    v_lshrrev_b32 v12, 2, v10
    v_lshl_add_u32 v12, v11, 3, v12
    v_lshlrev_b32 v5, 7, v12
    v_bfe_u32 v12, v10, 3, 1
    v_and_b32 v13, 1, v11
    v_lshl_or_b32 v12, v13, 1, v12
    v_xor_b32 v12, s33, v12
    v_lshl_add_u32 v5, v12, 5, v5
    v_and_b32 v13, 3, v10
    v_lshl_add_u32 v5, v13, 3, v5
    v_add_u32 v5, 71808, v5
    v_mov_b32 v6, v4
    v_add_u32 v7, 64, v4
    v_mov_b32 v8, v5
    v_mov_b32 v15, 153984
    s_mov_b32 s44, 0
    s_mov_b32 s45, 0
    v_lshlrev_b32 v11, 14, v11
    v_lshl_add_u32 v14, v10, 4, v11
    s_lshl_b32 s40, s33, 16
    v_add_u32 v14, s40, v14
    s_lshl_b32 s40, s31, 18
    s_lshl_b32 s41, s30, 10
    s_add_u32 s25, s40, s41
    s_lshl_b32 s41, s33, 2
    s_add_u32 s41, s41, s28
    s_lshl_b32 s41, s41, 7
    s_lshl_b32 s42, s29, 2
    s_add_u32 s41, s41, s42
    s_lshl_b32 s42, s31, 11
    s_add_u32 s41, s41, s42
    s_add_u32 s11, s41, 4194304
    v_mov_b32 v16, 0
    v_mov_b32 v17, 0
    v_mov_b32 v18, 0
    v_mov_b32 v19, 0
    v_mov_b32 v20, 0
    v_mov_b32 v21, 0
    v_mov_b32 v22, 0
    v_mov_b32 v23, 0
    v_mov_b32 v24, 0
    v_mov_b32 v25, 0
    v_mov_b32 v26, 0
    v_mov_b32 v27, 0
    v_mov_b32 v28, 0
    v_mov_b32 v29, 0
    v_mov_b32 v30, 0
    v_mov_b32 v31, 0
    v_mov_b32 v32, 0
    v_mov_b32 v33, 0
    v_mov_b32 v34, 0
    v_mov_b32 v35, 0
    v_mov_b32 v36, 0
    v_mov_b32 v37, 0
    v_mov_b32 v38, 0
    v_mov_b32 v39, 0
    v_mov_b32 v40, 0
    v_mov_b32 v41, 0
    v_mov_b32 v42, 0
    v_mov_b32 v43, 0
    v_mov_b32 v44, 0
    v_mov_b32 v45, 0
    v_mov_b32 v46, 0
    v_mov_b32 v47, 0
    v_and_b32 v164, 3, v1
    v_lshlrev_b32 v161, 5, v164
    v_add_u32 v161, 153728, v161
    v_bfe_u32 v164, v1, 2, 2
    v_lshrrev_b32 v165, 4, v1
    v_cmp_eq_u32 vcc, v164, v165
    v_and_b32 v166, 1, v1
    v_lshlrev_b32 v166, 4, v166
    v_mov_b32 v167, 0x3f80
    v_lshlrev_b32 v167, v166, v167
    v_cndmask_b32 v167, 0, v167, vcc
    v_bfe_u32 v164, v1, 1, 1
    v_cmp_eq_u32 vcc, 0, v164
    v_mov_b32 v158, 0
    v_lshlrev_b32 v157, 3, v1
    v_cndmask_b32 v136, 0, v167, vcc
    v_cndmask_b32 v137, v167, 0, vcc
    v_mov_b32 v138, v136
    v_mov_b32 v139, v137
    v_lshrrev_b32 v164, 4, v1
    v_and_b32 v165, 1, v164
    v_lshrrev_b32 v164, 1, v164
    v_lshl_or_b32 v164, v165, 1, v164
    v_lshlrev_b32 v164, 5, v164
    s_lshl_b32 s40, s32, 2
    s_add_u32 s40, s40, 153728
    v_add_u32 v160, s40, v164
    s_lshr_b32 s41, s32, 1
    s_and_b32 s42, s30, 12
    s_add_u32 s42, s42, s41
    s_lshl_b32 s42, s42, 7
    s_lshl_b32 s43, s31, 11
    s_add_u32 s42, s42, s43
    s_add_u32 s3, s42, 4194304
    s_lshl_b32 s40, s31, 18
    s_lshl_b32 s42, s30, 14
    s_add_u32 s40, s40, s42
    s_lshl_b32 s42, s41, 12
    s_add_u32 s40, s40, s42
    s_and_b32 s42, s32, 1
    s_lshl_b32 s43, s42, 9
    s_add_u32 s10, s40, s43
    s_lshl_b32 s41, s41, 7
    s_lshl_b32 s42, s42, 2
    s_add_u32 s41, s41, s42
    v_bfe_u32 v162, v1, 1, 4
    v_lshlrev_b32 v162, 3, v162
    v_lshrrev_b32 v166, 5, v1
    v_lshl_add_u32 v162, v166, 1, v162
    v_and_b32 v166, 1, v1
    v_add3_u32 v162, v162, v166, s41
    s_movk_i32 s43, 493
    v_cmp_gt_u32 s[80:81], s43, v162
    v_lshlrev_b32 v159, 10, v162
    s_mul_i32 s24, s26, 504832
    s_add_u32 s24, s24, s39
    v_mov_b32 v168, 0x40135761
    v_mov_b32 v170, 0x3dd2d3e8
    v_mov_b32 v172, 1.0
    v_mov_b32 v169, 0x40135761
    v_mov_b32 v171, 0x3dd2d3e8
    v_mov_b32 v173, 1.0
    s_waitcnt lgkmcnt(0)
    s_add_u32 s52, s52, 1
    s_lshl_b32 s40, s4, 16
    s_lshl_b32 s41, s8, 16
    v_mov_b32 v140, s40
    v_mov_b32 v144, s41
    s_and_b32 s40, s4, 0xffff0000
    s_and_b32 s41, s8, 0xffff0000
    v_mov_b32 v141, s40
    v_mov_b32 v145, s41
    s_lshl_b32 s40, s5, 16
    s_lshl_b32 s41, s9, 16
    v_mov_b32 v142, s40
    v_mov_b32 v146, s41
    s_and_b32 s40, s5, 0xffff0000
    s_and_b32 s41, s9, 0xffff0000
    v_mov_b32 v143, s40
    v_mov_b32 v147, s41
    v_and_b32 v164, 3, v1
    v_mov_b32 v165, s6
    v_mov_b32 v166, s7
    v_cmp_gt_u32 vcc, 2, v164
    v_and_b32 v167, 1, v1
    v_lshlrev_b32 v167, 4, v167
    v_cndmask_b32 v165, v166, v165, vcc
    v_sub_u32 v167, 16, v167
    v_lshlrev_b32 v165, v167, v165
    v_and_b32 v156, 0xffff0000, v165
    v_mov_b32 v163, s52
    s_waitcnt vmcnt(0)
    v_mov_b32 v10, 153988
    v_mov_b32 v11, 1
    s_mov_b64 exec, 1
    ds_add_u32 v10, v11
    s_mov_b64 exec, -1
L_b0spin:
    ds_read_b32 v11, v10
    s_waitcnt lgkmcnt(0)
    v_readfirstlane_b32 s40, v11
    s_cmp_ge_u32 s40, 4
    s_cbranch_scc0 L_b0spin
    ds_read_b64_tr_b16 v[120:121], v8
    ds_read_b64_tr_b16 v[122:123], v8 offset:512
    ds_read_b128 v[48:51], v6 offset:0
    ds_read_b128 v[52:55], v6 offset:128
    ds_read_b128 v[56:59], v6 offset:256
    ds_read_b128 v[60:63], v6 offset:384
    ds_read_b128 v[64:67], v6 offset:512
    ds_read_b128 v[68:71], v6 offset:640
    ds_read_b128 v[72:75], v6 offset:768
    ds_read_b128 v[76:79], v6 offset:896
L_kloop:
    s_waitcnt lgkmcnt(0)
    v_mfma_f32_16x16x32_bf16 v[16:19], v[120:123], v[48:51], v[16:19]
    ds_read_b128 v[80:83], v6 offset:1056
    v_mfma_f32_16x16x32_bf16 v[20:23], v[120:123], v[52:55], v[20:23]
    ds_read_b64_tr_b16 v[124:125], v8 offset:4096
    v_mfma_f32_16x16x32_bf16 v[24:27], v[120:123], v[56:59], v[24:27]
    ds_read_b64_tr_b16 v[126:127], v8 offset:4608
    v_mfma_f32_16x16x32_bf16 v[28:31], v[120:123], v[60:63], v[28:31]
    v_mfma_f32_16x16x32_bf16 v[32:35], v[120:123], v[64:67], v[32:35]
    v_mfma_f32_16x16x32_bf16 v[36:39], v[120:123], v[68:71], v[36:39]
    v_mfma_f32_16x16x32_bf16 v[40:43], v[120:123], v[72:75], v[40:43]
    v_mfma_f32_16x16x32_bf16 v[44:47], v[120:123], v[76:79], v[44:47]
    s_waitcnt lgkmcnt(0)
    v_mfma_f32_16x16x32_bf16 v[16:19], v[124:127], v[52:55], v[16:19]
    ds_read_b128 v[48:51], v6 offset:1184
    v_mfma_f32_16x16x32_bf16 v[20:23], v[124:127], v[56:59], v[20:23]
    ds_read_b64_tr_b16 v[128:129], v8 offset:8192
    v_mfma_f32_16x16x32_bf16 v[24:27], v[124:127], v[60:63], v[24:27]
    ds_read_b64_tr_b16 v[130:131], v8 offset:8704
    v_mfma_f32_16x16x32_bf16 v[28:31], v[124:127], v[64:67], v[28:31]
    v_mfma_f32_16x16x32_bf16 v[32:35], v[124:127], v[68:71], v[32:35]
    v_mfma_f32_16x16x32_bf16 v[36:39], v[124:127], v[72:75], v[36:39]
    v_mfma_f32_16x16x32_bf16 v[40:43], v[124:127], v[76:79], v[40:43]
    v_mfma_f32_16x16x32_bf16 v[44:47], v[124:127], v[80:83], v[44:47]
    s_waitcnt lgkmcnt(0)
    v_mfma_f32_16x16x32_bf16 v[16:19], v[128:131], v[56:59], v[16:19]
    ds_read_b128 v[52:55], v6 offset:1312
    v_mfma_f32_16x16x32_bf16 v[20:23], v[128:131], v[60:63], v[20:23]
    ds_read_b64_tr_b16 v[120:121], v8 offset:12288
    v_mfma_f32_16x16x32_bf16 v[24:27], v[128:131], v[64:67], v[24:27]
    ds_read_b64_tr_b16 v[122:123], v8 offset:12800
    v_mfma_f32_16x16x32_bf16 v[28:31], v[128:131], v[68:71], v[28:31]
    v_mfma_f32_16x16x32_bf16 v[32:35], v[128:131], v[72:75], v[32:35]
    v_mfma_f32_16x16x32_bf16 v[36:39], v[128:131], v[76:79], v[36:39]
    v_mfma_f32_16x16x32_bf16 v[40:43], v[128:131], v[80:83], v[40:43]
    v_mfma_f32_16x16x32_bf16 v[44:47], v[128:131], v[48:51], v[44:47]
    s_waitcnt lgkmcnt(0)
    v_mfma_f32_16x16x32_bf16 v[16:19], v[120:123], v[60:63], v[16:19]
    ds_read_b128 v[56:59], v6 offset:1440
    v_mfma_f32_16x16x32_bf16 v[20:23], v[120:123], v[64:67], v[20:23]
    ds_read_b64_tr_b16 v[124:125], v8 offset:16384
    v_mfma_f32_16x16x32_bf16 v[24:27], v[120:123], v[68:71], v[24:27]
    ds_read_b64_tr_b16 v[126:127], v8 offset:16896
    v_mfma_f32_16x16x32_bf16 v[28:31], v[120:123], v[72:75], v[28:31]
    v_mfma_f32_16x16x32_bf16 v[32:35], v[120:123], v[76:79], v[32:35]
    v_mfma_f32_16x16x32_bf16 v[36:39], v[120:123], v[80:83], v[36:39]
    v_mfma_f32_16x16x32_bf16 v[40:43], v[120:123], v[48:51], v[40:43]
    v_mfma_f32_16x16x32_bf16 v[44:47], v[120:123], v[52:55], v[44:47]
    s_add_u32 s44, s44, 20480
    s_cmp_eq_u32 s44, 81920
    s_cselect_b32 s44, 0, s44
    v_add_u32 v8, s44, v5
    s_waitcnt lgkmcnt(0)
    v_mfma_f32_16x16x32_bf16 v[16:19], v[124:127], v[64:67], v[16:19]
    s_barrier
    ds_read_b128 v[60:63], v6 offset:1568
    v_mfma_f32_16x16x32_bf16 v[20:23], v[124:127], v[68:71], v[20:23]
    ds_read_b64_tr_b16 v[128:129], v8 offset:0
    v_mfma_f32_16x16x32_bf16 v[24:27], v[124:127], v[72:75], v[24:27]
    ds_read_b64_tr_b16 v[130:131], v8 offset:512
    v_mfma_f32_16x16x32_bf16 v[28:31], v[124:127], v[76:79], v[28:31]
    v_mfma_f32_16x16x32_bf16 v[32:35], v[124:127], v[80:83], v[32:35]
    v_mfma_f32_16x16x32_bf16 v[36:39], v[124:127], v[48:51], v[36:39]
    v_mfma_f32_16x16x32_bf16 v[40:43], v[124:127], v[52:55], v[40:43]
    v_mfma_f32_16x16x32_bf16 v[44:47], v[124:127], v[56:59], v[44:47]
    s_waitcnt lgkmcnt(0)
    v_mfma_f32_16x16x32_bf16 v[16:19], v[128:131], v[68:71], v[16:19]
    ds_read_b128 v[64:67], v6 offset:1696
    v_mfma_f32_16x16x32_bf16 v[20:23], v[128:131], v[72:75], v[20:23]
    ds_read_b64_tr_b16 v[120:121], v8 offset:4096
    v_mfma_f32_16x16x32_bf16 v[24:27], v[128:131], v[76:79], v[24:27]
    ds_read_b64_tr_b16 v[122:123], v8 offset:4608
    v_mfma_f32_16x16x32_bf16 v[28:31], v[128:131], v[80:83], v[28:31]
    v_mfma_f32_16x16x32_bf16 v[32:35], v[128:131], v[48:51], v[32:35]
    v_mfma_f32_16x16x32_bf16 v[36:39], v[128:131], v[52:55], v[36:39]
    v_mfma_f32_16x16x32_bf16 v[40:43], v[128:131], v[56:59], v[40:43]
    v_mfma_f32_16x16x32_bf16 v[44:47], v[128:131], v[60:63], v[44:47]
    s_waitcnt lgkmcnt(0)
    v_mfma_f32_16x16x32_bf16 v[16:19], v[120:123], v[72:75], v[16:19]
    s_cmp_eq_u32 s45, 0
    s_cbranch_scc0 L_noob
    s_barrier
L_noob:
    ds_read_b128 v[68:71], v6 offset:1824
    v_mfma_f32_16x16x32_bf16 v[20:23], v[120:123], v[76:79], v[20:23]
    ds_read_b64_tr_b16 v[124:125], v8 offset:8192
    v_mfma_f32_16x16x32_bf16 v[24:27], v[120:123], v[80:83], v[24:27]
    ds_read_b64_tr_b16 v[126:127], v8 offset:8704
    v_mfma_f32_16x16x32_bf16 v[28:31], v[120:123], v[48:51], v[28:31]
    ds_read_b128 v[84:87], v6 offset:17952
    v_mfma_f32_16x16x32_bf16 v[32:35], v[120:123], v[52:55], v[32:35]
    ds_read_b128 v[88:91], v6 offset:18080
    v_mfma_f32_16x16x32_bf16 v[36:39], v[120:123], v[56:59], v[36:39]
    ds_read_b128 v[92:95], v6 offset:18208
    v_mfma_f32_16x16x32_bf16 v[40:43], v[120:123], v[60:63], v[40:43]
    ds_read_b128 v[96:99], v6 offset:18336
    v_mfma_f32_16x16x32_bf16 v[44:47], v[120:123], v[64:67], v[44:47]
    s_waitcnt lgkmcnt(4)
    v_mfma_f32_16x16x32_bf16 v[16:19], v[124:127], v[76:79], v[16:19]
    ds_read_b64_tr_b16 v[128:129], v8 offset:12288
    v_mfma_f32_16x16x32_bf16 v[20:23], v[124:127], v[80:83], v[20:23]
    ds_read_b64_tr_b16 v[130:131], v8 offset:12800
    v_mfma_f32_16x16x32_bf16 v[24:27], v[124:127], v[48:51], v[24:27]
    ds_read_b128 v[100:103], v6 offset:18464
    v_mfma_f32_16x16x32_bf16 v[28:31], v[124:127], v[52:55], v[28:31]
    ds_read_b128 v[104:107], v6 offset:18592
    v_mfma_f32_16x16x32_bf16 v[32:35], v[124:127], v[56:59], v[32:35]
    ds_read_b128 v[108:111], v6 offset:18720
    v_mfma_f32_16x16x32_bf16 v[36:39], v[124:127], v[60:63], v[36:39]
    ds_read_b128 v[112:115], v6 offset:18848
    v_mfma_f32_16x16x32_bf16 v[40:43], v[124:127], v[64:67], v[40:43]
    v_mfma_f32_16x16x32_bf16 v[44:47], v[124:127], v[68:71], v[44:47]
    s_waitcnt lgkmcnt(4)
    v_mfma_f32_16x16x32_bf16 v[16:19], v[128:131], v[84:87], v[16:19]
    ds_read_b128 v[116:119], v6 offset:19008
    v_mfma_f32_16x16x32_bf16 v[20:23], v[128:131], v[88:91], v[20:23]
    ds_read_b64_tr_b16 v[120:121], v8 offset:16384
    v_mfma_f32_16x16x32_bf16 v[24:27], v[128:131], v[92:95], v[24:27]
    ds_read_b64_tr_b16 v[122:123], v8 offset:16896
    v_mfma_f32_16x16x32_bf16 v[28:31], v[128:131], v[96:99], v[28:31]
    s_waitcnt lgkmcnt(3)
    v_mfma_f32_16x16x32_bf16 v[32:35], v[128:131], v[100:103], v[32:35]
    v_mfma_f32_16x16x32_bf16 v[36:39], v[128:131], v[104:107], v[36:39]
    v_mfma_f32_16x16x32_bf16 v[40:43], v[128:131], v[108:111], v[40:43]
    v_mfma_f32_16x16x32_bf16 v[44:47], v[128:131], v[112:115], v[44:47]
    s_add_u32 s44, s44, 20480
    s_cmp_eq_u32 s44, 81920
    s_cselect_b32 s44, 0, s44
    v_add_u32 v8, s44, v5
    s_waitcnt lgkmcnt(0)
    v_mfma_f32_16x16x32_bf16 v[16:19], v[120:123], v[88:91], v[16:19]
    s_barrier
    ds_read_b128 v[84:87], v6 offset:19136
    v_mfma_f32_16x16x32_bf16 v[20:23], v[120:123], v[92:95], v[20:23]
    ds_read_b64_tr_b16 v[124:125], v8 offset:0
    v_mfma_f32_16x16x32_bf16 v[24:27], v[120:123], v[96:99], v[24:27]
    ds_read_b64_tr_b16 v[126:127], v8 offset:512
    v_mfma_f32_16x16x32_bf16 v[28:31], v[120:123], v[100:103], v[28:31]
    v_mfma_f32_16x16x32_bf16 v[32:35], v[120:123], v[104:107], v[32:35]
    v_mfma_f32_16x16x32_bf16 v[36:39], v[120:123], v[108:111], v[36:39]
    v_mfma_f32_16x16x32_bf16 v[40:43], v[120:123], v[112:115], v[40:43]
    v_mfma_f32_16x16x32_bf16 v[44:47], v[120:123], v[116:119], v[44:47]
    s_waitcnt lgkmcnt(0)
    v_mfma_f32_16x16x32_bf16 v[16:19], v[124:127], v[92:95], v[16:19]
    ds_read_b32 v9, v15
    v_mfma_f32_16x16x32_bf16 v[20:23], v[124:127], v[96:99], v[20:23]
    ds_read_b128 v[88:91], v6 offset:19264
    v_mfma_f32_16x16x32_bf16 v[24:27], v[124:127], v[100:103], v[24:27]
    ds_read_b64_tr_b16 v[128:129], v8 offset:4096
    v_mfma_f32_16x16x32_bf16 v[28:31], v[124:127], v[104:107], v[28:31]
    ds_read_b64_tr_b16 v[130:131], v8 offset:4608
    v_mfma_f32_16x16x32_bf16 v[32:35], v[124:127], v[108:111], v[32:35]
    ds_read_b128 v[48:51], v7 offset:0
    v_mfma_f32_16x16x32_bf16 v[36:39], v[124:127], v[112:115], v[36:39]
    ds_read_b128 v[52:55], v7 offset:128
    v_mfma_f32_16x16x32_bf16 v[40:43], v[124:127], v[116:119], v[40:43]
    ds_read_b128 v[56:59], v7 offset:256
    v_mfma_f32_16x16x32_bf16 v[44:47], v[124:127], v[84:87], v[44:47]
    s_waitcnt lgkmcnt(3)
    v_mfma_f32_16x16x32_bf16 v[16:19], v[128:131], v[96:99], v[16:19]
    ds_read_b128 v[92:95], v6 offset:19392
    v_mfma_f32_16x16x32_bf16 v[20:23], v[128:131], v[100:103], v[20:23]
    ds_read_b64_tr_b16 v[120:121], v8 offset:8192
    v_mfma_f32_16x16x32_bf16 v[24:27], v[128:131], v[104:107], v[24:27]
    ds_read_b64_tr_b16 v[122:123], v8 offset:8704
    v_mfma_f32_16x16x32_bf16 v[28:31], v[128:131], v[108:111], v[28:31]
    ds_read_b128 v[60:63], v7 offset:384
    v_mfma_f32_16x16x32_bf16 v[32:35], v[128:131], v[112:115], v[32:35]
    ds_read_b128 v[64:67], v7 offset:512
    v_mfma_f32_16x16x32_bf16 v[36:39], v[128:131], v[116:119], v[36:39]
    ds_read_b128 v[68:71], v7 offset:640
    v_mfma_f32_16x16x32_bf16 v[40:43], v[128:131], v[84:87], v[40:43]
    v_mfma_f32_16x16x32_bf16 v[44:47], v[128:131], v[88:91], v[44:47]
    s_waitcnt lgkmcnt(3)
    v_mfma_f32_16x16x32_bf16 v[16:19], v[120:123], v[100:103], v[16:19]
    ds_read_b128 v[96:99], v6 offset:19520
    v_mfma_f32_16x16x32_bf16 v[20:23], v[120:123], v[104:107], v[20:23]
    ds_read_b64_tr_b16 v[124:125], v8 offset:12288
    v_mfma_f32_16x16x32_bf16 v[24:27], v[120:123], v[108:111], v[24:27]
    ds_read_b64_tr_b16 v[126:127], v8 offset:12800
    v_mfma_f32_16x16x32_bf16 v[28:31], v[120:123], v[112:115], v[28:31]
    ds_read_b128 v[72:75], v7 offset:768
    v_mfma_f32_16x16x32_bf16 v[32:35], v[120:123], v[116:119], v[32:35]
    ds_read_b128 v[76:79], v7 offset:896
    v_mfma_f32_16x16x32_bf16 v[36:39], v[120:123], v[84:87], v[36:39]
    v_mfma_f32_16x16x32_bf16 v[40:43], v[120:123], v[88:91], v[40:43]
    v_mfma_f32_16x16x32_bf16 v[44:47], v[120:123], v[92:95], v[44:47]
    s_waitcnt lgkmcnt(2)
    v_mfma_f32_16x16x32_bf16 v[16:19], v[124:127], v[104:107], v[16:19]
    ds_read_b128 v[100:103], v6 offset:19648
    v_mfma_f32_16x16x32_bf16 v[20:23], v[124:127], v[108:111], v[20:23]
    ds_read_b64_tr_b16 v[128:129], v8 offset:16384
    v_mfma_f32_16x16x32_bf16 v[24:27], v[124:127], v[112:115], v[24:27]
    ds_read_b64_tr_b16 v[130:131], v8 offset:16896
    v_mfma_f32_16x16x32_bf16 v[28:31], v[124:127], v[116:119], v[28:31]
    v_mfma_f32_16x16x32_bf16 v[32:35], v[124:127], v[84:87], v[32:35]
    v_mfma_f32_16x16x32_bf16 v[36:39], v[124:127], v[88:91], v[36:39]
    v_mfma_f32_16x16x32_bf16 v[40:43], v[124:127], v[92:95], v[40:43]
    s_cmp_eq_u32 s45, 3
    v_mfma_f32_16x16x32_bf16 v[44:47], v[124:127], v[96:99], v[44:47]
    s_cbranch_scc1 L_lasttap
    s_add_u32 s44, s44, 20480
    s_cmp_eq_u32 s44, 81920
    s_cselect_b32 s44, 0, s44
    v_add_u32 v8, s44, v5
    s_waitcnt lgkmcnt(0)
    v_mfma_f32_16x16x32_bf16 v[16:19], v[128:131], v[108:111], v[16:19]
    s_barrier
    ds_read_b64_tr_b16 v[120:121], v8 offset:0
    v_mfma_f32_16x16x32_bf16 v[20:23], v[128:131], v[112:115], v[20:23]
    ds_read_b64_tr_b16 v[122:123], v8 offset:512
    v_mfma_f32_16x16x32_bf16 v[24:27], v[128:131], v[116:119], v[24:27]
    s_add_u32 s45, s45, 1
    v_mov_b32 v6, v7
    v_mfma_f32_16x16x32_bf16 v[28:31], v[128:131], v[84:87], v[28:31]
    s_add_u32 s41, s45, 1
    s_lshr_b32 s42, s41, 1
    v_mfma_f32_16x16x32_bf16 v[32:35], v[128:131], v[88:91], v[32:35]
    s_mul_i32 s42, s42, 35904
    s_and_b32 s41, s41, 1
    v_mfma_f32_16x16x32_bf16 v[36:39], v[128:131], v[92:95], v[36:39]
    s_lshl_b32 s41, s41, 6
    s_add_u32 s41, s41, s42
    v_mfma_f32_16x16x32_bf16 v[40:43], v[128:131], v[96:99], v[40:43]
    v_add_u32 v7, s41, v4
    v_mfma_f32_16x16x32_bf16 v[44:47], v[128:131], v[100:103], v[44:47]
    s_branch L_kloop
L_lasttap:
    s_waitcnt lgkmcnt(0)
    v_readfirstlane_b32 s46, v9
    v_mfma_f32_16x16x32_bf16 v[16:19], v[128:131], v[108:111], v[16:19]
    s_nop 0
    v_mfma_f32_16x16x32_bf16 v[20:23], v[128:131], v[112:115], v[20:23]
    s_nop 0
    v_mfma_f32_16x16x32_bf16 v[24:27], v[128:131], v[116:119], v[24:27]
    s_cmp_eq_u32 s46, 1
    v_mfma_f32_16x16x32_bf16 v[28:31], v[128:131], v[84:87], v[28:31]
    s_cbranch_scc1 L_fast
    v_mfma_f32_16x16x32_bf16 v[32:35], v[128:131], v[88:91], v[32:35]
    s_nop 0
    v_mfma_f32_16x16x32_bf16 v[36:39], v[128:131], v[92:95], v[36:39]
    s_nop 0
    v_mfma_f32_16x16x32_bf16 v[40:43], v[128:131], v[96:99], v[40:43]
    s_nop 0
    v_cvt_pk_bf16_f32 v48, v16, v17
    v_mfma_f32_16x16x32_bf16 v[44:47], v[128:131], v[100:103], v[44:47]
    v_cvt_pk_bf16_f32 v49, v18, v19
    v_cvt_pk_bf16_f32 v50, v20, v21
    v_cvt_pk_bf16_f32 v51, v22, v23
    buffer_store_dwordx4 v[48:51], v14, s[20:23], s25 offen offset:0 sc1
    v_cvt_pk_bf16_f32 v52, v24, v25
    v_cvt_pk_bf16_f32 v53, v26, v27
    v_cvt_pk_bf16_f32 v54, v28, v29
    v_cvt_pk_bf16_f32 v55, v30, v31
    buffer_store_dwordx4 v[52:55], v14, s[20:23], s25 offen offset:256 sc1
    v_cvt_pk_bf16_f32 v56, v32, v33
    v_cvt_pk_bf16_f32 v57, v34, v35
    v_cvt_pk_bf16_f32 v58, v36, v37
    v_cvt_pk_bf16_f32 v59, v38, v39
    buffer_store_dwordx4 v[56:59], v14, s[20:23], s25 offen offset:512 sc1
    v_cvt_pk_bf16_f32 v60, v40, v41
    v_cvt_pk_bf16_f32 v61, v42, v43
    v_cvt_pk_bf16_f32 v62, v44, v45
    v_cvt_pk_bf16_f32 v63, v46, v47
    buffer_store_dwordx4 v[60:63], v14, s[20:23], s25 offen offset:768 sc1
    s_waitcnt vmcnt(0)
    s_mov_b64 exec, 1
    buffer_store_dword v163, v158, s[20:23], s11 offen sc1
    s_mov_b64 exec, -1
    s_branch L_final
L_fast:
    v_mfma_f32_16x16x32_bf16 v[32:35], v[128:131], v[88:91], v[32:35]
    s_nop 0
    v_mfma_f32_16x16x32_bf16 v[36:39], v[128:131], v[92:95], v[36:39]
    s_nop 0
    v_mfma_f32_16x16x32_bf16 v[40:43], v[128:131], v[96:99], v[40:43]
    s_nop 0
    v_cvt_pk_bf16_f32 v48, v16, v17
    v_mfma_f32_16x16x32_bf16 v[44:47], v[128:131], v[100:103], v[44:47]
    v_cvt_pk_bf16_f32 v49, v18, v19
    v_cvt_pk_bf16_f32 v50, v20, v21
    v_cvt_pk_bf16_f32 v51, v22, v23
    buffer_store_dwordx4 v[48:51], v14, s[20:23], s25 offen offset:0
    v_cvt_pk_bf16_f32 v52, v24, v25
    v_cvt_pk_bf16_f32 v53, v26, v27
    v_cvt_pk_bf16_f32 v54, v28, v29
    v_cvt_pk_bf16_f32 v55, v30, v31
    buffer_store_dwordx4 v[52:55], v14, s[20:23], s25 offen offset:256
    v_cvt_pk_bf16_f32 v56, v32, v33
    v_cvt_pk_bf16_f32 v57, v34, v35
    v_cvt_pk_bf16_f32 v58, v36, v37
    v_cvt_pk_bf16_f32 v59, v38, v39
    buffer_store_dwordx4 v[56:59], v14, s[20:23], s25 offen offset:512
    v_cvt_pk_bf16_f32 v60, v40, v41
    v_cvt_pk_bf16_f32 v61, v42, v43
    v_cvt_pk_bf16_f32 v62, v44, v45
    v_cvt_pk_bf16_f32 v63, v46, v47
    buffer_store_dwordx4 v[60:63], v14, s[20:23], s25 offen offset:768
    s_waitcnt vmcnt(0)
    s_mov_b64 exec, 1
    buffer_store_dword v163, v158, s[20:23], s11 offen
    s_mov_b64 exec, -1
L_final:
    s_mov_b32 s45, 0
    buffer_load_dwordx4 v[20:23], v158, s[20:23], s3 offen sc1
L_flagpoll:
    buffer_load_dwordx4 v[24:27], v158, s[20:23], s3 offen sc1
    s_waitcnt vmcnt(1)
    v_xor_b32 v20, s52, v20
    v_xor_b32 v21, s52, v21
    v_xor_b32 v22, s52, v22
    v_xor_b32 v23, s52, v23
    v_or3_b32 v20, v20, v21, v22
    v_or_b32 v20, v20, v23
    s_add_u32 s45, s45, 1
    v_readfirstlane_b32 s41, v20
    s_cmp_eq_u32 s41, 0
    s_cbranch_scc1 L_flagok
    buffer_load_dwordx4 v[20:23], v158, s[20:23], s3 offen sc1
    s_waitcnt vmcnt(1)
    v_xor_b32 v24, s52, v24
    v_xor_b32 v25, s52, v25
    v_xor_b32 v26, s52, v26
    v_xor_b32 v27, s52, v27
    v_or3_b32 v24, v24, v25, v26
    v_or_b32 v24, v24, v27
    s_add_u32 s45, s45, 1
    v_readfirstlane_b32 s41, v24
    s_cmp_eq_u32 s41, 0
    s_cbranch_scc1 L_flagok
    s_cmp_ge_u32 s45, 200000
    s_cbranch_scc0 L_flagpoll
L_flagok:
    buffer_load_dwordx2 v[40:41], v157, s[20:23], s10 offen offset:0 sc1
    buffer_load_dwordx2 v[42:43], v157, s[20:23], s10 offen offset:1024 sc1
    buffer_load_dwordx2 v[44:45], v157, s[20:23], s10 offen offset:2048 sc1
    buffer_load_dwordx2 v[46:47], v157, s[20:23], s10 offen offset:3072 sc1
    s_waitcnt vmcnt(2)
    v_mfma_f32_16x16x32_bf16 v[16:19], v[136:139], v[40:43], v[140:143]
    s_waitcnt vmcnt(0)
    v_mfma_f32_16x16x32_bf16 v[16:19], v[136:139], v[44:47], v[16:19]
    s_nop 7
    v_cndmask_b32 v28, 0, v16, s[80:81]
    v_cndmask_b32 v29, 0, v17, s[80:81]
    v_cndmask_b32 v30, 0, v18, s[80:81]
    v_cndmask_b32 v31, 0, v19, s[80:81]
    v_mul_f32 v148, v28, v28
    v_mul_f32 v149, v29, v29
    v_mul_f32 v150, v30, v30
    v_mul_f32 v151, v31, v31
    v_permlane32_swap_b32 v28, v29
    v_permlane32_swap_b32 v30, v31
    v_permlane32_swap_b32 v148, v149
    v_permlane32_swap_b32 v150, v151
    v_add_f32 v28, v28, v29
    v_add_f32 v30, v30, v31
    v_add_f32 v148, v148, v149
    v_add_f32 v150, v150, v151
    s_nop 0
    v_permlane16_swap_b32 v28, v30
    v_permlane16_swap_b32 v148, v150
    v_add_f32 v28, v28, v30
    v_add_f32 v148, v148, v150
    s_nop 0
    v_add_f32_dpp v28, v28, v28 row_ror:8 row_mask:0xf bank_mask:0xf
    v_add_f32_dpp v148, v148, v148 row_ror:8 row_mask:0xf bank_mask:0xf
    s_nop 0
    v_add_f32_dpp v28, v28, v28 row_ror:4 row_mask:0xf bank_mask:0xf
    v_add_f32_dpp v148, v148, v148 row_ror:4 row_mask:0xf bank_mask:0xf
    s_nop 0
    v_add_f32_dpp v28, v28, v28 row_ror:2 row_mask:0xf bank_mask:0xf
    v_add_f32_dpp v148, v148, v148 row_ror:2 row_mask:0xf bank_mask:0xf
    s_nop 0
    v_add_f32_dpp v28, v28, v28 row_ror:1 row_mask:0xf bank_mask:0xf
    v_add_f32_dpp v148, v148, v148 row_ror:1 row_mask:0xf bank_mask:0xf
    s_mov_b32 exec_lo, 0x00010001
    s_mov_b32 exec_hi, 0x00010001
    ds_write_b32 v160, v28
    ds_write_b32 v160, v148 offset:128
    s_mov_b64 exec, -1
    s_waitcnt lgkmcnt(0)
    s_barrier
    ds_read_b128 v[28:31], v161
    ds_read_b128 v[32:35], v161 offset:16
    ds_read_b128 v[148:151], v161 offset:128
    ds_read_b128 v[152:155], v161 offset:144
    s_waitcnt lgkmcnt(2)
    v_pk_add_f32 v[28:29], v[28:29], v[30:31]
    v_pk_add_f32 v[32:33], v[32:33], v[34:35]
    s_waitcnt lgkmcnt(0)
    v_pk_add_f32 v[148:149], v[148:149], v[150:151]
    v_pk_add_f32 v[152:153], v[152:153], v[154:155]
    v_pk_add_f32 v[28:29], v[28:29], v[32:33]
    v_pk_add_f32 v[148:149], v[148:149], v[152:153]
    v_add_f32 v28, v28, v29
    v_add_f32 v148, v148, v149
    v_mul_f32 v28, 0x3b04eedd, v28
    v_mul_f32 v148, 0x3b04eedd, v148
    v_mul_f32 v30, v28, v28
    v_sub_f32 v148, v148, v30
    v_mul_f32 v31, 0x43800000, v148
    v_cmp_gt_f32 vcc, v30, v31
    v_subrev_f32_dpp v16, v28, v16 quad_perm:[0,0,0,0] row_mask:0xf bank_mask:0xf
    v_subrev_f32_dpp v17, v28, v17 quad_perm:[1,1,1,1] row_mask:0xf bank_mask:0xf
    v_subrev_f32_dpp v18, v28, v18 quad_perm:[2,2,2,2] row_mask:0xf bank_mask:0xf
    v_subrev_f32_dpp v19, v28, v19 quad_perm:[3,3,3,3] row_mask:0xf bank_mask:0xf
    s_cmp_lg_u64 vcc, 0
    s_cbranch_scc0 L_varok
    v_mul_f32 v148, v16, v16
    v_mul_f32 v149, v17, v17
    v_mul_f32 v150, v18, v18
    v_mul_f32 v151, v19, v19
    v_cndmask_b32 v148, 0, v148, s[80:81]
    v_cndmask_b32 v149, 0, v149, s[80:81]
    v_cndmask_b32 v150, 0, v150, s[80:81]
    v_cndmask_b32 v151, 0, v151, s[80:81]
    s_nop 1
    v_permlane32_swap_b32 v148, v149
    v_permlane32_swap_b32 v150, v151
    v_add_f32 v148, v148, v149
    v_add_f32 v150, v150, v151
    s_nop 1
    v_permlane16_swap_b32 v148, v150
    v_add_f32 v148, v148, v150
    s_nop 1
    v_add_f32_dpp v148, v148, v148 row_ror:8 row_mask:0xf bank_mask:0xf
    s_nop 1
    v_add_f32_dpp v148, v148, v148 row_ror:4 row_mask:0xf bank_mask:0xf
    s_nop 1
    v_add_f32_dpp v148, v148, v148 row_ror:2 row_mask:0xf bank_mask:0xf
    s_nop 1
    v_add_f32_dpp v148, v148, v148 row_ror:1 row_mask:0xf bank_mask:0xf
    s_mov_b32 exec_lo, 0x00010001
    s_mov_b32 exec_hi, 0x00010001
    ds_write_b32 v160, v148 offset:384
    s_mov_b64 exec, -1
    s_waitcnt lgkmcnt(0)
    s_barrier
    ds_read_b128 v[148:151], v161 offset:384
    ds_read_b128 v[152:155], v161 offset:400
    s_waitcnt lgkmcnt(0)
    v_pk_add_f32 v[148:149], v[148:149], v[150:151]
    v_pk_add_f32 v[152:153], v[152:153], v[154:155]
    v_pk_add_f32 v[148:149], v[148:149], v[152:153]
    v_add_f32 v148, v148, v149
    v_mul_f32 v148, 0x3b04eedd, v148
L_varok:
    v_add_f32 v29, 0x3727c5ac, v148
    v_rsq_f32 v29, v29
    s_nop 0
    v_mul_f32 v29, v29, v156
    s_nop 1
    v_fmac_f32_dpp v144, v29, v16 quad_perm:[0,0,0,0] row_mask:0xf bank_mask:0xf
    v_fmac_f32_dpp v145, v29, v17 quad_perm:[1,1,1,1] row_mask:0xf bank_mask:0xf
    v_fmac_f32_dpp v146, v29, v18 quad_perm:[2,2,2,2] row_mask:0xf bank_mask:0xf
    v_fmac_f32_dpp v147, v29, v19 quad_perm:[3,3,3,3] row_mask:0xf bank_mask:0xf
    v_pk_mul_f32 v[30:31], v[144:145], v[144:145]
    v_pk_mul_f32 v[32:33], v[146:147], v[146:147]
    v_pk_fma_f32 v[30:31], v[30:31], v[170:171], v[168:169]
    v_pk_fma_f32 v[32:33], v[32:33], v[170:171], v[168:169]
    v_pk_mul_f32 v[30:31], v[144:145], v[30:31]
    v_pk_mul_f32 v[32:33], v[146:147], v[32:33]
    v_exp_f32 v30, -v30
    v_exp_f32 v31, -v31
    v_exp_f32 v32, -v32
    v_exp_f32 v33, -v33
    s_nop 0
    v_pk_add_f32 v[30:31], v[30:31], v[172:173]
    v_pk_add_f32 v[32:33], v[32:33], v[172:173]
    v_rcp_f32 v30, v30
    v_rcp_f32 v31, v31
    v_rcp_f32 v32, v32
    v_rcp_f32 v33, v33
    s_nop 0
    v_pk_mul_f32 v[144:145], v[144:145], v[30:31]
    v_pk_mul_f32 v[146:147], v[146:147], v[32:33]
    v_cvt_pk_bf16_f32 v30, v144, v145
    v_cvt_pk_bf16_f32 v31, v146, v147
    s_mov_b64 exec, s[80:81]
    buffer_store_dwordx2 v[30:31], v159, s[48:51], s24 offen
    s_or_b32 s40, s30, s32
    s_cmp_eq_u32 s40, 0
    s_cbranch_scc0 L_noepoch
    s_lshl_b32 s41, s31, 7
    s_add_u32 s41, s41, 4227072
    s_mov_b64 exec, 1
    buffer_store_dword v163, v158, s[20:23], s41 offen
L_noepoch:
    s_endpgm
L_loader:
    s_add_u32 m0, s38, 40960
    s_add_u32 s40, s37, 2621440
    buffer_load_dwordx4 v3, s[16:19], s40 offen lds
    s_add_u32 m0, s38, 45056
    s_add_u32 s40, s37, 3670016
    buffer_load_dwordx4 v3, s[16:19], s40 offen lds
    s_add_u32 m0, s38, 49152
    s_add_u32 s40, s37, 4718592
    buffer_load_dwordx4 v3, s[16:19], s40 offen lds
    s_add_u32 m0, s38, 53248
    s_add_u32 s40, s37, 5767168
    buffer_load_dwordx4 v3, s[16:19], s40 offen lds
    s_add_u32 m0, s38, 57344
    s_add_u32 s40, s37, 6815744
    buffer_load_dwordx4 v3, s[16:19], s40 offen lds
    s_mov_b32 s20, s78
    s_and_b32 s21, s79, 0xffff
    s_mov_b32 s22, 268435456
    s_mov_b32 s23, 0x20000
    s_mov_b32 s48, s74
    s_and_b32 s49, s75, 0xffff
    s_mov_b32 s50, 1009664
    s_mov_b32 s51, 0x20000
    s_load_dwordx2 s[4:5], s[68:69], s39
    s_load_dwordx2 s[6:7], s[70:71], s39
    s_load_dwordx2 s[8:9], s[72:73], s39
    s_lshl_b32 s41, s31, 7
    s_add_u32 s41, s41, 4227072
    s_load_dword s52, s[78:79], s41
    s_add_u32 m0, s38, 61440
    s_add_u32 s40, s37, 32768
    buffer_load_dwordx4 v3, s[16:19], s40 offen lds
    s_add_u32 m0, s38, 65536
    s_add_u32 s40, s37, 1081344
    buffer_load_dwordx4 v3, s[16:19], s40 offen lds
    s_add_u32 m0, s38, 69632
    s_add_u32 s40, s37, 2129920
    buffer_load_dwordx4 v3, s[16:19], s40 offen lds
    s_add_u32 m0, s38, 73728
    s_add_u32 s40, s37, 3178496
    buffer_load_dwordx4 v3, s[16:19], s40 offen lds
    s_add_u32 m0, s38, 77824
    s_add_u32 s40, s37, 4227072
    buffer_load_dwordx4 v3, s[16:19], s40 offen lds
    s_cmp_ge_u32 s33, 2
    s_cbranch_scc1 L_mallx
    v_lshrrev_b32 v20, 1, v1
    v_min_u32 v20, 29, v20
    v_lshlrev_b32 v20, 10, v20
    v_and_b32 v21, 1, v1
    v_lshl_or_b32 v20, v21, 6, v20
    s_mul_i32 s40, s2, 30720
    s_lshl_b32 s41, s33, 9
    s_add_u32 s40, s40, s41
    s_add_u32 s40, s40, 384
    buffer_load_dword v134, v20, s[16:19], s40 offen
    s_branch L_nomallpf
L_mallx:
    v_bfe_u32 v20, v1, 1, 3
    s_lshl_b32 s40, s2, 3
    v_add_u32 v20, s40, v20
    v_min_u32 v20, 1999, v20
    v_lshlrev_b32 v20, 10, v20
    v_and_b32 v21, 1, v1
    v_lshl_or_b32 v20, v21, 6, v20
    s_and_b32 s40, s33, 1
    s_lshl_b32 s40, s40, 9
    s_add_u32 s40, s40, 384
    v_add_u32 v20, s40, v20
    global_load_dword v134, v20, s[64:65]
L_nomallpf:
    s_waitcnt lgkmcnt(0)
    s_add_u32 s52, s52, 1
    s_getreg_b32 s47, hwreg(HW_REG_XCC_ID, 0, 3)
    s_lshl_b32 s53, s52, 3
    s_or_b32 s53, s53, s47
    s_lshl_b32 s42, s31, 7
    s_add_u32 s54, s42, 4229120
    s_cmp_eq_u32 s33, 0
    s_cbranch_scc0 L_noarrive
    s_lshl_b32 s42, s30, 2
    s_add_u32 s42, s42, s54
    v_mov_b32 v11, s53
    v_mov_b32 v12, 0
    s_mov_b64 exec, 1
    buffer_store_dword v11, v12, s[20:23], s42 offen sc1
    s_mov_b64 exec, -1
L_noarrive:
    s_waitcnt vmcnt(15)
    s_barrier
    s_waitcnt vmcnt(11)
    s_barrier
    s_add_u32 m0, s38, 0
    s_add_u32 s40, s37, 5275648
    buffer_load_dwordx4 v3, s[16:19], s40 offen lds
    s_add_u32 m0, s38, 4096
    s_add_u32 s40, s37, 6324224
    buffer_load_dwordx4 v3, s[16:19], s40 offen lds
    s_add_u32 m0, s38, 8192
    s_add_u32 s40, s37, 7372800
    buffer_load_dwordx4 v3, s[16:19], s40 offen lds
    s_add_u32 m0, s38, 12288
    s_add_u32 s40, s37, 557056
    buffer_load_dwordx4 v3, s[16:19], s40 offen lds
    s_add_u32 m0, s38, 16384
    s_add_u32 s40, s37, 1605632
    buffer_load_dwordx4 v3, s[16:19], s40 offen lds
    s_add_u32 m0, s36, 35904
    s_add_u32 s40, s35, 128
    buffer_load_dwordx4 v2, s[12:15], s40 offen lds
    s_add_u32 m0, s36, 40128
    s_add_u32 s40, s35, 65664
    buffer_load_dwordx4 v2, s[12:15], s40 offen lds
    s_waitcnt vmcnt(13)
    s_barrier
    s_add_u32 m0, s38, 20480
    s_add_u32 s40, s37, 2654208
    buffer_load_dwordx4 v3, s[16:19], s40 offen lds
    s_add_u32 m0, s38, 24576
    s_add_u32 s40, s37, 3702784
    buffer_load_dwordx4 v3, s[16:19], s40 offen lds
    s_add_u32 m0, s38, 28672
    s_add_u32 s40, s37, 4751360
    buffer_load_dwordx4 v3, s[16:19], s40 offen lds
    s_add_u32 m0, s38, 32768
    s_add_u32 s40, s37, 5799936
    buffer_load_dwordx4 v3, s[16:19], s40 offen lds
    s_add_u32 m0, s38, 36864
    s_add_u32 s40, s37, 6848512
    buffer_load_dwordx4 v3, s[16:19], s40 offen lds
    s_add_u32 m0, s36, 44352
    s_add_u32 s40, s35, 131200
    buffer_load_dwordx4 v2, s[12:15], s40 offen lds
    s_add_u32 m0, s36, 48576
    s_add_u32 s40, s35, 196736
    buffer_load_dwordx4 v2, s[12:15], s40 offen lds
    s_waitcnt vmcnt(15)
    s_barrier
    s_cmp_eq_u32 s33, 2
    s_cbranch_scc0 L_skipx2
    s_mov_b32 m0, 52800
    s_add_u32 s40, s34, 262272
    buffer_load_dwordx4 v2, s[12:15], s40 offen lds
L_skipx2:
    s_add_u32 m0, s38, 40960
    s_add_u32 s40, s37, 65536
    buffer_load_dwordx4 v3, s[16:19], s40 offen lds
    s_add_u32 m0, s38, 45056
    s_add_u32 s40, s37, 1114112
    buffer_load_dwordx4 v3, s[16:19], s40 offen lds
    s_add_u32 m0, s38, 49152
    s_add_u32 s40, s37, 2162688
    buffer_load_dwordx4 v3, s[16:19], s40 offen lds
    s_add_u32 m0, s38, 53248
    s_add_u32 s40, s37, 3211264
    buffer_load_dwordx4 v3, s[16:19], s40 offen lds
    s_add_u32 m0, s38, 57344
    s_add_u32 s40, s37, 4259840
    buffer_load_dwordx4 v3, s[16:19], s40 offen lds
    s_add_u32 m0, s36, 53856
    s_add_u32 s40, s35, 1152
    buffer_load_dwordx4 v2, s[12:15], s40 offen lds
    s_waitcnt vmcnt(15)
    s_barrier
    s_add_u32 m0, s38, 61440
    s_add_u32 s40, s37, 5308416
    buffer_load_dwordx4 v3, s[16:19], s40 offen lds
    s_add_u32 m0, s38, 65536
    s_add_u32 s40, s37, 6356992
    buffer_load_dwordx4 v3, s[16:19], s40 offen lds
    s_add_u32 m0, s38, 69632
    s_add_u32 s40, s37, 7405568
    buffer_load_dwordx4 v3, s[16:19], s40 offen lds
    s_add_u32 m0, s38, 73728
    s_add_u32 s40, s37, 589824
    buffer_load_dwordx4 v3, s[16:19], s40 offen lds
    s_add_u32 m0, s38, 77824
    s_add_u32 s40, s37, 1638400
    buffer_load_dwordx4 v3, s[16:19], s40 offen lds
    s_add_u32 m0, s36, 58080
    s_add_u32 s40, s35, 66688
    buffer_load_dwordx4 v2, s[12:15], s40 offen lds
    s_add_u32 m0, s36, 62304
    s_add_u32 s40, s35, 132224
    buffer_load_dwordx4 v2, s[12:15], s40 offen lds
    s_waitcnt vmcnt(13)
    s_barrier
    s_add_u32 m0, s36, 66528
    s_add_u32 s40, s35, 197760
    buffer_load_dwordx4 v2, s[12:15], s40 offen lds
    s_cmp_eq_u32 s33, 3
    s_cbranch_scc0 L_skipx3
    s_mov_b32 m0, 70752
    s_add_u32 s40, s34, 263296
    buffer_load_dwordx4 v2, s[12:15], s40 offen lds
L_skipx3:
    s_add_u32 m0, s38, 0
    s_add_u32 s40, s37, 2686976
    buffer_load_dwordx4 v3, s[16:19], s40 offen lds
    s_add_u32 m0, s38, 4096
    s_add_u32 s40, s37, 3735552
    buffer_load_dwordx4 v3, s[16:19], s40 offen lds
    s_add_u32 m0, s38, 8192
    s_add_u32 s40, s37, 4784128
    buffer_load_dwordx4 v3, s[16:19], s40 offen lds
    s_add_u32 m0, s38, 12288
    s_add_u32 s40, s37, 5832704
    buffer_load_dwordx4 v3, s[16:19], s40 offen lds
    s_add_u32 m0, s38, 16384
    s_add_u32 s40, s37, 6881280
    buffer_load_dwordx4 v3, s[16:19], s40 offen lds
    s_waitcnt vmcnt(14)
    s_barrier
    s_add_u32 m0, s38, 20480
    s_add_u32 s40, s37, 98304
    buffer_load_dwordx4 v3, s[16:19], s40 offen lds
    s_add_u32 m0, s38, 24576
    s_add_u32 s40, s37, 1146880
    buffer_load_dwordx4 v3, s[16:19], s40 offen lds
    s_add_u32 m0, s38, 28672
    s_add_u32 s40, s37, 2195456
    buffer_load_dwordx4 v3, s[16:19], s40 offen lds
    s_add_u32 m0, s38, 32768
    s_add_u32 s40, s37, 3244032
    buffer_load_dwordx4 v3, s[16:19], s40 offen lds
    s_add_u32 m0, s38, 36864
    s_add_u32 s40, s37, 4292608
    buffer_load_dwordx4 v3, s[16:19], s40 offen lds
    v_and_b32 v12, 15, v1
    v_lshlrev_b32 v12, 2, v12
    buffer_load_dword v24, v12, s[20:23], s54 offen sc1
    s_waitcnt vmcnt(11)
    s_barrier
    s_add_u32 m0, s38, 40960
    s_add_u32 s40, s37, 5341184
    buffer_load_dwordx4 v3, s[16:19], s40 offen lds
    s_add_u32 m0, s38, 45056
    s_add_u32 s40, s37, 6389760
    buffer_load_dwordx4 v3, s[16:19], s40 offen lds
    s_add_u32 m0, s38, 49152
    s_add_u32 s40, s37, 7438336
    buffer_load_dwordx4 v3, s[16:19], s40 offen lds
    s_add_u32 m0, s38, 53248
    s_add_u32 s40, s37, 622592
    buffer_load_dwordx4 v3, s[16:19], s40 offen lds
    s_add_u32 m0, s38, 57344
    s_add_u32 s40, s37, 1671168
    buffer_load_dwordx4 v3, s[16:19], s40 offen lds
    s_waitcnt vmcnt(11)
    s_barrier
    s_add_u32 m0, s38, 61440
    s_add_u32 s40, s37, 2719744
    buffer_load_dwordx4 v3, s[16:19], s40 offen lds
    s_add_u32 m0, s38, 65536
    s_add_u32 s40, s37, 3768320
    buffer_load_dwordx4 v3, s[16:19], s40 offen lds
    s_add_u32 m0, s38, 69632
    s_add_u32 s40, s37, 4816896
    buffer_load_dwordx4 v3, s[16:19], s40 offen lds
    s_add_u32 m0, s38, 73728
    s_add_u32 s40, s37, 5865472
    buffer_load_dwordx4 v3, s[16:19], s40 offen lds
    s_add_u32 m0, s38, 77824
    s_add_u32 s40, s37, 6914048
    buffer_load_dwordx4 v3, s[16:19], s40 offen lds
    v_and_b32 v11, 31, v1
    v_lshlrev_b32 v11, 7, v11
    s_lshl_b32 s41, s31, 18
    s_lshl_b32 s42, s30, 14
    s_add_u32 s41, s41, s42
    s_lshl_b32 s42, s33, 12
    s_add_u32 s41, s41, s42
    buffer_load_dword v10, v11, s[20:23], s41 offen sc1
    s_mul_i32 s41, s26, 504832
    s_add_u32 s41, s41, s39
    v_mov_b32 v20, 0
    buffer_load_dword v21, v20, s[48:51], s41 offen
    s_waitcnt vmcnt(13)
    s_barrier
    v_and_b32 v164, 3, v1
    v_lshlrev_b32 v161, 5, v164
    v_add_u32 v161, 153728, v161
    v_bfe_u32 v164, v1, 2, 2
    v_lshrrev_b32 v165, 4, v1
    v_cmp_eq_u32 vcc, v164, v165
    v_and_b32 v166, 1, v1
    v_lshlrev_b32 v166, 4, v166
    v_mov_b32 v167, 0x3f80
    v_lshlrev_b32 v167, v166, v167
    v_cndmask_b32 v167, 0, v167, vcc
    v_bfe_u32 v164, v1, 1, 1
    v_cmp_eq_u32 vcc, 0, v164
    v_mov_b32 v158, 0
    v_lshlrev_b32 v157, 3, v1
    v_cndmask_b32 v136, 0, v167, vcc
    v_cndmask_b32 v137, v167, 0, vcc
    v_mov_b32 v138, v136
    v_mov_b32 v139, v137
    v_lshrrev_b32 v164, 4, v1
    v_and_b32 v165, 1, v164
    v_lshrrev_b32 v164, 1, v164
    v_lshl_or_b32 v164, v165, 1, v164
    v_lshlrev_b32 v164, 5, v164
    s_lshl_b32 s40, s32, 2
    s_add_u32 s40, s40, 153728
    v_add_u32 v160, s40, v164
    s_lshr_b32 s41, s32, 1
    s_and_b32 s42, s30, 12
    s_add_u32 s42, s42, s41
    s_lshl_b32 s42, s42, 7
    s_lshl_b32 s43, s31, 11
    s_add_u32 s42, s42, s43
    s_add_u32 s3, s42, 4194304
    s_lshl_b32 s40, s31, 18
    s_lshl_b32 s42, s30, 14
    s_add_u32 s40, s40, s42
    s_lshl_b32 s42, s41, 12
    s_add_u32 s40, s40, s42
    s_and_b32 s42, s32, 1
    s_lshl_b32 s43, s42, 9
    s_add_u32 s10, s40, s43
    s_lshl_b32 s41, s41, 7
    s_lshl_b32 s42, s42, 2
    s_add_u32 s41, s41, s42
    v_bfe_u32 v162, v1, 1, 4
    v_lshlrev_b32 v162, 3, v162
    v_lshrrev_b32 v166, 5, v1
    v_lshl_add_u32 v162, v166, 1, v162
    v_and_b32 v166, 1, v1
    v_add3_u32 v162, v162, v166, s41
    s_movk_i32 s43, 493
    v_cmp_gt_u32 s[80:81], s43, v162
    v_lshlrev_b32 v159, 10, v162
    s_mul_i32 s24, s26, 504832
    s_add_u32 s24, s24, s39
    v_mov_b32 v168, 0x40135761
    v_mov_b32 v170, 0x3dd2d3e8
    v_mov_b32 v172, 1.0
    v_mov_b32 v169, 0x40135761
    v_mov_b32 v171, 0x3dd2d3e8
    v_mov_b32 v173, 1.0
    s_lshl_b32 s40, s4, 16
    s_lshl_b32 s41, s8, 16
    v_mov_b32 v140, s40
    v_mov_b32 v144, s41
    s_and_b32 s40, s4, 0xffff0000
    s_and_b32 s41, s8, 0xffff0000
    v_mov_b32 v141, s40
    v_mov_b32 v145, s41
    s_lshl_b32 s40, s5, 16
    s_lshl_b32 s41, s9, 16
    v_mov_b32 v142, s40
    v_mov_b32 v146, s41
    s_and_b32 s40, s5, 0xffff0000
    s_and_b32 s41, s9, 0xffff0000
    v_mov_b32 v143, s40
    v_mov_b32 v147, s41
    v_and_b32 v164, 3, v1
    v_mov_b32 v165, s6
    v_mov_b32 v166, s7
    v_cmp_gt_u32 vcc, 2, v164
    v_and_b32 v167, 1, v1
    v_lshlrev_b32 v167, 4, v167
    v_cndmask_b32 v165, v166, v165, vcc
    v_sub_u32 v167, 16, v167
    v_lshlrev_b32 v165, v167, v165
    v_and_b32 v156, 0xffff0000, v165
    v_mov_b32 v163, s52
    s_waitcnt vmcnt(7)
    s_barrier
    s_mov_b32 s45, 0
    s_lshr_b32 s43, s53, 3
L_cntpoll:
    v_lshrrev_b32 v25, 3, v24
    v_cmp_eq_u32 vcc, s43, v25
    s_nop 4
    s_cmp_eq_u64 vcc, exec
    s_cbranch_scc1 L_cntok
    s_add_u32 s45, s45, 1
    s_cmp_ge_u32 s45, 200000
    s_cbranch_scc1 L_cntok
    s_sleep 2
    buffer_load_dword v24, v12, s[20:23], s54 offen sc1
    s_waitcnt vmcnt(0)
    s_branch L_cntpoll
L_cntok:
    v_cmp_eq_u32 vcc, s53, v24
    s_nop 4
    s_cmp_eq_u64 vcc, exec
    s_cselect_b32 s46, 1, 0
    v_mov_b32 v11, s46
    v_mov_b32 v12, 153984
    s_mov_b64 exec, 1
    ds_write_b32 v12, v11
    s_mov_b64 exec, -1
    s_waitcnt lgkmcnt(0)
    s_waitcnt vmcnt(2)
    s_barrier
    s_branch L_final
L_end:
    s_endpgm
.section .rodata,"a"
.p2align 6
.amdhsa_kernel standalone__self_sup_conv_stem_hubert__speech_kernel
  .amdhsa_next_free_vgpr 176
  .amdhsa_next_free_sgpr 102
  .amdhsa_accum_offset 176
  .amdhsa_group_segment_fixed_size 0
  .amdhsa_kernarg_size 64
  .amdhsa_user_sgpr_count 2
  .amdhsa_user_sgpr_kernarg_segment_ptr 1
  .amdhsa_system_sgpr_workgroup_id_x 1
.end_amdhsa_kernel
```
